```python
import torch

def _softmax(x, axis=-1):
    return torch.softmax(x, dim=axis)
def _gelu(x):
    return torch.nn.functional.gelu(x, approximate="tanh")
def _silu(x):
    return torch.nn.functional.silu(x)
def _sigmoid(x):
    return torch.sigmoid(x)
def _layernorm(x, axis=-1, eps=1e-5):
    m = x.mean(dim=axis, keepdim=True)
    v = x.var(dim=axis, keepdim=True, unbiased=False)
    return (x - m) / torch.sqrt(v + eps)
def _scatter_add(tgt, idx, src, axis=0):
    return tgt.clone().index_add_(axis, idx, src)
def _segment_sum(src, seg, n):
    out = torch.zeros((n,) + src.shape[1:], dtype=src.dtype)
    return out.index_add_(0, seg, src)
def _pad(x, pw):
    flat = tuple(v for pair in reversed(pw) for v in pair)
    return torch.nn.functional.pad(x, flat)

kernel_name = 'recurrent_scan__sliding_block_cached__mixer_token_mlp__decode'

def setup_inputs():

    _w = (lambda a: (lambda t: t.to(torch.bfloat16) if t.is_floating_point() else t)(torch.as_tensor(a)))
    def _A_setup():
        B, Sq, D = 1, 1, 1024
        Hq, Hkv, Sk, Dh = 32, 4, 65536, 128
        assert Hq % Hkv == 0, (Hq, Hkv)
        return {
            "x": _w((lambda *s: torch.randn(*s, dtype=torch.bfloat16) * 0.05)(B, Sq, D)),
            "k_cache": _w((lambda *s: torch.randn(*s, dtype=torch.bfloat16) * 1.6)(B, Hkv, Sk, Dh)),
            "v_cache": _w((lambda *s: torch.randn(*s, dtype=torch.bfloat16) * 1.6)(B, Hkv, Sk, Dh)),
            "wq": _w((lambda *s: torch.randn(*s, dtype=torch.bfloat16) * 1.6)(D, Hq * Dh) * (D ** -0.5)),
            "wo": _w((lambda *s: torch.randn(*s, dtype=torch.bfloat16) * 1.6)(Hq * Dh, D) * ((Hq * Dh) ** -0.5)),
        }
    _A_in = _A_setup()

    def _B_setup():
        B, S, D, F = 1, 1, 1024, 3584
        return {
            "x": _w((lambda *s: torch.randn(*s, dtype=torch.bfloat16) * 0.05)(B, S, D)),
            "w1": _w((lambda *s: torch.randn(*s, dtype=torch.bfloat16) * 0.2)(S, F) * (S ** -0.5)),
            "b1": _w((lambda *s: torch.randn(*s, dtype=torch.bfloat16) * 0.2)(F) * 0.02),
            "w2": _w((lambda *s: torch.randn(*s, dtype=torch.bfloat16) * 0.2)(F, S) * (F ** -0.5)),
            "b2": _w((lambda *s: torch.randn(*s, dtype=torch.bfloat16) * 0.2)(S) * 0.02),
        }
    _B_in = _B_setup()

    return {
        "A_x": _A_in["x"],
        "A_k_cache": _A_in["k_cache"],
        "A_v_cache": _A_in["v_cache"],
        "A_wq": _A_in["wq"],
        "A_wo": _A_in["wo"],
        "B_x": _B_in["x"],
        "B_w1": _B_in["w1"],
        "B_b1": _B_in["b1"],
        "B_w2": _B_in["w2"],
        "B_b2": _B_in["b2"],
    }

def reference(A_x, A_k_cache, A_v_cache, A_wq, A_wo, B_x, B_w1, B_b1, B_w2, B_b2):
    def _A_ref(x, k_cache, v_cache, wq, wo):
        B, Sq, D = x.shape
        Hq, Dh = 32, 128
        Hkv, Sk = k_cache.shape[1], k_cache.shape[2]
        W = min(4096, max(256, Sk // 4))
        rep = Hq // Hkv
        q = (lambda x, *d: x.permute(*d))((x @ wq).reshape(B, Sq, Hq, Dh), 0, 2, 1, 3)
        k = (lambda x, n, axis: torch.repeat_interleave(x, n, dim=axis))(k_cache[:, :, Sk - W:, :], rep, axis=1)
        v = (lambda x, n, axis: torch.repeat_interleave(x, n, dim=axis))(v_cache[:, :, Sk - W:, :], rep, axis=1)
        scores = torch.einsum("bhqd,bhkd->bhqk", q, k) * (Dh ** -0.5)
        p = _softmax(scores, axis=-1)
        o = torch.einsum("bhqk,bhkd->bhqd", p, v)
        return (lambda x, *d: x.permute(*d))(o, 0, 2, 1, 3).reshape(B, Sq, Hq * Dh) @ wo

    def _B_ref(x, w1, b1, w2, b2):
        B, S, D = x.shape
        h = _layernorm(x, axis=-1)
        u = torch.einsum("bsd,sf->bdf", h, w1) + b1
        u = _gelu(u)
        y = torch.einsum("bdf,fs->bds", u, w2) + b2
        return (lambda x, *d: x.permute(*d))(y, 0, 2, 1)

    x = A_x
    xn = _layernorm(x, axis=-1)
    s = _A_ref(xn, A_k_cache, A_v_cache, A_wq, A_wo)
    g = _silu(_B_ref(xn, B_w1, B_b1, B_w2, B_b2))
    return x + s * g
```

```asm
; @launch grid=(256,1,1) block=(512,1,1) lds=63296
.amdgcn_target "amdgcn-amd-amdhsa--gfx950"
.text
.globl recurrent_scan__sliding_block_cached__mixer_token_mlp__decode_kernel
.p2align 8
.type recurrent_scan__sliding_block_cached__mixer_token_mlp__decode_kernel,@function
recurrent_scan__sliding_block_cached__mixer_token_mlp__decode_kernel:
    s_cmp_ge_u32 s2, 256
    s_cbranch_scc1 Lend
    s_load_dwordx16 s[4:19], s[0:1], 0
    s_load_dwordx8 s[20:27], s[0:1], 64
    s_load_dwordx2 s[28:29], s[0:1], 96
    v_lshrrev_b32 v3, 6, v0
    v_and_b32 v1, 63, v0
    s_lshr_b32 s32, s2, 3
    v_readfirstlane_b32 s33, v3
    s_and_b32 s31, s2, 7
    s_cmp_ge_u32 s33, 4
    s_cbranch_scc1 LproKV
    s_and_b32 s36, s32, 3
    s_lshl_b32 s36, s36, 8
    s_lshl_b32 s37, s33, 6
    s_add_u32 s36, s36, s37
    v_and_b32 v2, 56, v1
    v_add_u32 v2, s36, v2
    s_lshl_b32 s37, s31, 10
    s_lshr_b32 s38, s32, 2
    s_lshl_b32 s38, s38, 7
    s_add_u32 s37, s37, s38
    v_and_b32 v149, 7, v1
    v_lshlrev_b32 v3, 1, v2
    v_lshl_add_u32 v149, v149, 4, s37
    s_movk_i32 s44, 0x2000
    v_lshl_add_u32 v148, v2, 13, v149
    v_add_u32 v149, s44, v148
    v_add_u32 v150, s44, v149
    v_add_u32 v151, s44, v150
    v_add_u32 v152, s44, v151
    v_add_u32 v153, s44, v152
    v_add_u32 v154, s44, v153
    v_add_u32 v155, s44, v154
    v_lshlrev_b32 v4, 5, v1
    s_waitcnt lgkmcnt(0)
    s_cmp_lg_u32 s33, 0
    s_cbranch_scc1 Lnox
    global_load_dwordx4 v[124:127], v4, s[4:5]
    global_load_dwordx4 v[128:131], v4, s[4:5] offset:16
    v_mov_b32 v2, 0
    global_load_dword v35, v2, s[28:29] offset:0 sc1
Lnox:
    global_load_dwordx4 v[12:15], v3, s[4:5]
    global_load_dwordx4 v[76:79], v148, s[10:11]
    global_load_dwordx4 v[80:83], v149, s[10:11]
    global_load_dwordx4 v[84:87], v150, s[10:11]
    global_load_dwordx4 v[88:91], v151, s[10:11]
    global_load_dwordx4 v[92:95], v152, s[10:11]
    global_load_dwordx4 v[96:99], v153, s[10:11]
    global_load_dwordx4 v[100:103], v154, s[10:11]
    global_load_dwordx4 v[104:107], v155, s[10:11]
    s_setprio 2
    s_lshl_b32 s30, s31, 5
    s_add_u32 s30, s30, s32
    s_lshl_b32 s37, s30, 3
    v_mov_b32 v5, s37
    v_mov_b32 v10, 0
    v_mov_b32 v27, 1
    global_load_dwordx2 v[18:19], v5, s[4:5]
    s_barrier
    v_mov_b32 v204, 0
    v_mov_b32 v205, 0
    v_mov_b32 v206, 0
    v_mov_b32 v207, 0
    v_mov_b32 v208, 0
    v_mov_b32 v209, 0
    v_mov_b32 v210, 0
    v_mov_b32 v211, 0
    v_mov_b32 v212, 0
    v_mov_b32 v213, 0
    v_mov_b32 v214, 0
    v_mov_b32 v215, 0
    v_mov_b32 v216, 0
    v_mov_b32 v217, 0
    v_mov_b32 v218, 0
    v_mov_b32 v219, 0
    v_mov_b32 v220, 0
    v_mov_b32 v221, 0
    v_mov_b32 v222, 0
    v_mov_b32 v223, 0
    v_mov_b32 v224, 0
    v_mov_b32 v225, 0
    v_mov_b32 v226, 0
    v_mov_b32 v227, 0
    v_mov_b32 v228, 0
    v_mov_b32 v229, 0
    v_mov_b32 v230, 0
    v_mov_b32 v231, 0
    v_mov_b32 v232, 0
    v_lshlrev_b32 v24, 4, v0
    v_and_b32 v114, 15, v1
    v_lshrrev_b32 v115, 4, v1
    v_and_b32 v116, 7, v1
    v_and_b32 v117, 3, v1
    v_lshlrev_b32 v2, 4, v117
    v_mov_b32 v108, 0xffff
    v_mov_b32 v109, 0
    v_lshlrev_b64 v[108:109], v2, v[108:109]
    v_and_b32 v2, 4, v1
    v_cmp_eq_u32 vcc, 0, v2
    s_nop 1
    v_cndmask_b32 v6, 0, v108, vcc
    v_cndmask_b32 v7, 0, v109, vcc
    v_cndmask_b32 v8, v108, v10, vcc
    v_cndmask_b32 v9, v109, v10, vcc
    s_mov_b32 s46, 0x07060500
    s_mov_b32 s47, 0x07060501
    s_mov_b32 s48, 0x07060502
    s_mov_b32 s49, 0x07060503
    s_mov_b32 s52, 0x01000100
    s_mov_b32 s53, 0x03020302
    v_lshrrev_b32 v110, 5, v1
    s_lshl_b32 s36, s33, 1
    v_add_u32 v110, s36, v110
    v_mul_u32_u24 v110, 272, v110
    v_lshlrev_b32 v111, 5, v116
    v_and_b32 v112, 16, v1
    v_add3_u32 v204, v110, v111, v112
    v_mul_u32_u24 v110, 544, v117
    v_lshrrev_b32 v111, 2, v1
    v_lshl_add_u32 v205, v111, 4, v110
    s_lshl_b32 s36, s31, 13
    s_and_b32 s37, s32, 3
    s_lshl_b32 s37, s37, 11
    s_add_u32 s36, s36, s37
    s_lshr_b32 s37, s32, 2
    s_lshl_b32 s37, s37, 8
    s_add_u32 s36, s36, s37
    s_add_u32 s36, s36, 0x1000
    v_lshl_add_u32 v206, v111, 4, s36
    v_add_u32 v207, 23360, v24
    s_waitcnt vmcnt(9)
    s_cmp_lg_u32 s33, 0
    s_cbranch_scc1 Lnostats
    v_mov_b32 v132, 0
    v_mov_b32 v133, 0
    s_mov_b32 s39, 0x3f803f80
    v_dot2c_f32_bf16 v132, s39, v124
    v_dot2c_f32_bf16 v133, v124, v124
    v_dot2c_f32_bf16 v132, s39, v125
    v_dot2c_f32_bf16 v133, v125, v125
    v_dot2c_f32_bf16 v132, s39, v126
    v_dot2c_f32_bf16 v133, v126, v126
    v_dot2c_f32_bf16 v132, s39, v127
    v_dot2c_f32_bf16 v133, v127, v127
    v_dot2c_f32_bf16 v132, s39, v128
    v_dot2c_f32_bf16 v133, v128, v128
    v_dot2c_f32_bf16 v132, s39, v129
    v_dot2c_f32_bf16 v133, v129, v129
    v_dot2c_f32_bf16 v132, s39, v130
    v_dot2c_f32_bf16 v133, v130, v130
    v_dot2c_f32_bf16 v132, s39, v131
    v_dot2c_f32_bf16 v133, v131, v131
    s_nop 1
    v_add_f32_dpp v132, v132, v132 row_ror:8 row_mask:0xf bank_mask:0xf
    v_add_f32_dpp v133, v133, v133 row_ror:8 row_mask:0xf bank_mask:0xf
    s_nop 0
    v_add_f32_dpp v132, v132, v132 row_ror:4 row_mask:0xf bank_mask:0xf
    v_add_f32_dpp v133, v133, v133 row_ror:4 row_mask:0xf bank_mask:0xf
    s_nop 0
    v_add_f32_dpp v132, v132, v132 row_ror:2 row_mask:0xf bank_mask:0xf
    v_add_f32_dpp v133, v133, v133 row_ror:2 row_mask:0xf bank_mask:0xf
    s_nop 0
    v_add_f32_dpp v132, v132, v132 row_ror:1 row_mask:0xf bank_mask:0xf
    v_add_f32_dpp v133, v133, v133 row_ror:1 row_mask:0xf bank_mask:0xf
    s_nop 0
    v_add_f32_dpp v132, v132, v132 row_bcast:15 row_mask:0xa bank_mask:0xf
    v_add_f32_dpp v133, v133, v133 row_bcast:15 row_mask:0xa bank_mask:0xf
    s_nop 0
    v_add_f32_dpp v132, v132, v132 row_bcast:31 row_mask:0xc bank_mask:0xf
    v_add_f32_dpp v133, v133, v133 row_bcast:31 row_mask:0xc bank_mask:0xf
    v_readlane_b32 s36, v132, 63
    v_readlane_b32 s37, v133, 63
    s_nop 0
    v_mov_b32 v138, s36
    v_mov_b32 v139, s37
    v_mul_f32 v138, 0x3a800000, v138
    v_mul_f32 v139, 0x3a800000, v139
    v_mul_f32 v134, v138, v138
    v_sub_f32 v139, v139, v134
    v_mul_f32 v135, 0x41800000, v139
    v_cmp_gt_f32 vcc, v134, v135
    s_cbranch_vccnz Lstat2
Lstat3:
    v_cvt_pk_bf16_f32 v136, v138, v138
    v_lshlrev_b32 v136, 16, v136
    v_cvt_pk_bf16_f32 v134, v139, v139
    v_lshlrev_b32 v134, 16, v134
    v_add_f32 v134, 0x3727c5ac, v134
    v_cvt_pk_bf16_f32 v134, v134, v134
    v_lshlrev_b32 v134, 16, v134
    v_sqrt_f32 v134, v134
    s_nop 0
    v_cvt_pk_bf16_f32 v134, v134, v134
    v_lshlrev_b32 v134, 16, v134
    v_rcp_f32 v137, v134
    s_mov_b32 s36, 0x9E3779B1
    v_mul_lo_u32 v11, v35, s36
    v_add_u32 v11, 0x7F4A7C15, v11
    s_mov_b32 exec_lo, 0x1
    s_mov_b32 exec_hi, 0x0
    ds_write_b128 v10, v[136:139] offset:23296
    ds_write_b32 v10, v11 offset:23312
    ds_write_b32 v10, v35 offset:23316
    s_waitcnt lgkmcnt(0)
    ds_add_u32 v10, v27 offset:23328
    s_mov_b64 exec, -1
Lnostats:
    s_mov_b32 s45, 33554432
Lls1:
    ds_read_b32 v2, v10 offset:23328
    s_waitcnt lgkmcnt(0)
    v_cmp_gt_u32 vcc, 1, v2
    s_cbranch_vccz Lls1_ok
    s_sub_u32 s45, s45, 1
    s_cmp_lg_u32 s45, 0
    s_cbranch_scc1 Lls1
    s_branch Lend
Lls1_ok:
    ds_read_b128 v[28:31], v10 offset:23296
    s_waitcnt lgkmcnt(0)
    v_lshlrev_b32 v108, 16, v12
    v_and_b32 v109, 0xffff0000, v12
    v_lshlrev_b32 v110, 16, v13
    v_and_b32 v111, 0xffff0000, v13
    v_lshlrev_b32 v112, 16, v14
    v_and_b32 v113, 0xffff0000, v14
    v_lshlrev_b32 v114, 16, v15
    v_and_b32 v115, 0xffff0000, v15
    v_pk_add_f32 v[108:109], v[108:109], v[28:29] op_sel_hi:[1,0] neg_lo:[0,1] neg_hi:[0,1]
    v_pk_add_f32 v[110:111], v[110:111], v[28:29] op_sel_hi:[1,0] neg_lo:[0,1] neg_hi:[0,1]
    v_pk_add_f32 v[112:113], v[112:113], v[28:29] op_sel_hi:[1,0] neg_lo:[0,1] neg_hi:[0,1]
    v_pk_add_f32 v[114:115], v[114:115], v[28:29] op_sel_hi:[1,0] neg_lo:[0,1] neg_hi:[0,1]
    v_cvt_pk_bf16_f32 v12, v108, v109
    v_cvt_pk_bf16_f32 v13, v110, v111
    v_cvt_pk_bf16_f32 v14, v112, v113
    v_cvt_pk_bf16_f32 v15, v114, v115
    v_lshlrev_b32 v108, 16, v12
    v_and_b32 v109, 0xffff0000, v12
    v_lshlrev_b32 v110, 16, v13
    v_and_b32 v111, 0xffff0000, v13
    v_lshlrev_b32 v112, 16, v14
    v_and_b32 v113, 0xffff0000, v14
    v_lshlrev_b32 v114, 16, v15
    v_and_b32 v115, 0xffff0000, v15
    v_pk_mul_f32 v[108:109], v[108:109], v[28:29] op_sel:[0,1] op_sel_hi:[1,1]
    v_pk_mul_f32 v[110:111], v[110:111], v[28:29] op_sel:[0,1] op_sel_hi:[1,1]
    v_pk_mul_f32 v[112:113], v[112:113], v[28:29] op_sel:[0,1] op_sel_hi:[1,1]
    v_pk_mul_f32 v[114:115], v[114:115], v[28:29] op_sel:[0,1] op_sel_hi:[1,1]
    v_cvt_pk_bf16_f32 v12, v108, v109
    v_cvt_pk_bf16_f32 v13, v110, v111
    v_cvt_pk_bf16_f32 v14, v112, v113
    v_cvt_pk_bf16_f32 v15, v114, v115
    v_perm_b32 v36, v12, v12, s52
    v_perm_b32 v37, v12, v12, s53
    v_perm_b32 v38, v13, v13, s52
    v_perm_b32 v39, v13, v13, s53
    v_perm_b32 v40, v14, v14, s52
    v_perm_b32 v41, v14, v14, s53
    v_perm_b32 v42, v15, v15, s52
    v_perm_b32 v43, v15, v15, s53
    v_and_b32 v44, v36, v6
    v_and_b32 v45, v36, v7
    v_and_b32 v46, v36, v8
    v_and_b32 v47, v36, v9
    v_and_b32 v48, v37, v6
    v_and_b32 v49, v37, v7
    v_and_b32 v50, v37, v8
    v_and_b32 v51, v37, v9
    v_and_b32 v52, v38, v6
    v_and_b32 v53, v38, v7
    v_and_b32 v54, v38, v8
    v_and_b32 v55, v38, v9
    v_and_b32 v56, v39, v6
    v_and_b32 v57, v39, v7
    v_and_b32 v58, v39, v8
    v_and_b32 v59, v39, v9
    v_and_b32 v60, v40, v6
    v_and_b32 v61, v40, v7
    v_and_b32 v62, v40, v8
    v_and_b32 v63, v40, v9
    v_and_b32 v64, v41, v6
    v_and_b32 v65, v41, v7
    v_and_b32 v66, v41, v8
    v_and_b32 v67, v41, v9
    v_and_b32 v68, v42, v6
    v_and_b32 v69, v42, v7
    v_and_b32 v70, v42, v8
    v_and_b32 v71, v42, v9
    v_and_b32 v72, v43, v6
    v_and_b32 v73, v43, v7
    v_and_b32 v74, v43, v8
    v_and_b32 v75, v43, v9
    s_waitcnt vmcnt(8)
    v_mfma_f32_16x16x32_bf16 v[116:119], v[44:47], v[76:79], 0
    s_waitcnt vmcnt(7)
    v_mfma_f32_16x16x32_bf16 v[116:119], v[48:51], v[80:83], v[116:119]
    s_waitcnt vmcnt(6)
    v_mfma_f32_16x16x32_bf16 v[116:119], v[52:55], v[84:87], v[116:119]
    s_waitcnt vmcnt(5)
    v_mfma_f32_16x16x32_bf16 v[116:119], v[56:59], v[88:91], v[116:119]
    s_waitcnt vmcnt(4)
    v_mfma_f32_16x16x32_bf16 v[116:119], v[60:63], v[92:95], v[116:119]
    s_waitcnt vmcnt(3)
    v_mfma_f32_16x16x32_bf16 v[116:119], v[64:67], v[96:99], v[116:119]
    s_waitcnt vmcnt(2)
    v_mfma_f32_16x16x32_bf16 v[116:119], v[68:71], v[100:103], v[116:119]
    s_waitcnt vmcnt(0)
    v_mfma_f32_16x16x32_bf16 v[116:119], v[72:75], v[104:107], v[116:119]
    s_mov_b32 exec_lo, 0xff00ff
    s_mov_b32 exec_hi, 0xff00ff00
    s_nop 5
    ds_write_b128 v204, v[116:119] offset:16384
    s_mov_b64 exec, -1
    s_mov_b32 exec_lo, 0x1
    s_mov_b32 exec_hi, 0x0
    s_waitcnt lgkmcnt(0)
    ds_add_u32 v10, v27 offset:23332
    s_mov_b64 exec, -1
    s_cmp_lg_u32 s33, 0
    s_cbranch_scc1 Lnopub
    s_mov_b32 s45, 33554432
Lls2:
    ds_read_b32 v2, v10 offset:23332
    s_waitcnt lgkmcnt(0)
    v_cmp_gt_u32 vcc, 4, v2
    s_cbranch_vccz Lls2_ok
    s_sub_u32 s45, s45, 1
    s_cmp_lg_u32 s45, 0
    s_cbranch_scc1 Lls2
    s_branch Lend
Lls2_ok:
    ds_read_b128 v[76:79], v205 offset:16384
    ds_read_b128 v[80:83], v205 offset:16656
    s_waitcnt lgkmcnt(0)
    v_pk_add_f32 v[76:77], v[76:77], v[80:81]
    v_pk_add_f32 v[78:79], v[78:79], v[82:83]
    s_nop 0
    v_add_f32_dpp v76, v76, v76 quad_perm:[1,0,3,2] row_mask:0xf bank_mask:0xf
    v_add_f32_dpp v77, v77, v77 quad_perm:[1,0,3,2] row_mask:0xf bank_mask:0xf
    v_add_f32_dpp v78, v78, v78 quad_perm:[1,0,3,2] row_mask:0xf bank_mask:0xf
    v_add_f32_dpp v79, v79, v79 quad_perm:[1,0,3,2] row_mask:0xf bank_mask:0xf
    v_add_f32_dpp v76, v76, v76 quad_perm:[2,3,0,1] row_mask:0xf bank_mask:0xf
    v_add_f32_dpp v77, v77, v77 quad_perm:[2,3,0,1] row_mask:0xf bank_mask:0xf
    v_add_f32_dpp v78, v78, v78 quad_perm:[2,3,0,1] row_mask:0xf bank_mask:0xf
    v_add_f32_dpp v79, v79, v79 quad_perm:[2,3,0,1] row_mask:0xf bank_mask:0xf
    v_perm_b32 v76, v76, v11, s46
    v_perm_b32 v77, v77, v11, s47
    v_perm_b32 v78, v78, v11, s48
    v_perm_b32 v79, v79, v11, s49
    s_mov_b32 exec_lo, 0x11111111
    s_mov_b32 exec_hi, 0x11111111
    global_store_dwordx4 v206, v[76:79], s[28:29] sc1
    s_mov_b64 exec, -1
Lnopub:
    s_setprio 0
    s_mov_b32 s40, 0xbdd2d3e8
    s_mov_b32 s41, s40
    s_mov_b32 s42, 1.0
    s_mov_b32 s43, 1.0
    s_call_b64 s[96:97], Lh
    global_load_dwordx4 v[124:127], v24, s[16:17]
    global_load_dwordx4 v[128:131], v24, s[18:19]
    global_load_dwordx4 v[132:135], v24, s[20:21]
    s_cmp_eq_u32 s33, 0
    s_cbranch_scc1 Lq0
    s_barrier
    s_barrier
    s_waitcnt vmcnt(0)
    s_call_b64 s[96:97], Lgelu
    s_waitcnt lgkmcnt(0)
    s_barrier
    s_branch Ldone
Lq0:
    v_and_b32 v114, 15, v1
    v_lshrrev_b32 v115, 4, v1
    v_and_b32 v116, 7, v1
    v_and_b32 v117, 3, v1
    s_lshr_b32 s36, s32, 4
    s_lshl_b32 s36, s36, 1
    s_lshl_b32 s37, s31, 2
    s_add_u32 s36, s36, s37
    s_lshl_b32 s36, s36, 7
    s_lshr_b32 s37, s32, 2
    s_and_b32 s37, s37, 3
    s_lshl_b32 s37, s37, 5
    s_add_u32 s36, s36, s37
    v_bfe_u32 v111, v1, 4, 1
    v_lshlrev_b32 v111, 7, v111
    v_bfe_u32 v112, v1, 5, 1
    v_lshl_add_u32 v111, v112, 4, v111
    v_and_b32 v112, 8, v1
    v_add3_u32 v111, v111, v112, s36
    v_lshlrev_b32 v111, 11, v111
    s_and_b32 s36, s32, 3
    s_lshl_b32 s36, s36, 9
    v_lshl_add_u32 v112, v116, 4, s36
    v_add_u32 v226, v111, v112
    s_movk_i32 s36, 0x800
    v_mov_b32 v172, v226
    v_add_u32 v173, s36, v172
    v_add_u32 v174, s36, v173
    v_add_u32 v175, s36, v174
    v_add_u32 v176, s36, v175
    v_add_u32 v177, s36, v176
    v_add_u32 v178, s36, v177
    v_add_u32 v179, s36, v178
    s_barrier
    s_setprio 1
    s_mov_b32 m0, 30528
    s_nop 0
    global_load_lds_dwordx4 v172, s[12:13] offset:0
    s_mov_b32 m0, 31552
    s_nop 0
    global_load_lds_dwordx4 v173, s[12:13] offset:0
    s_mov_b32 m0, 32576
    s_nop 0
    global_load_lds_dwordx4 v174, s[12:13] offset:0
    s_mov_b32 m0, 33600
    s_nop 0
    global_load_lds_dwordx4 v175, s[12:13] offset:0
    s_mov_b32 m0, 34624
    s_nop 0
    global_load_lds_dwordx4 v176, s[12:13] offset:0
    s_mov_b32 m0, 35648
    s_nop 0
    global_load_lds_dwordx4 v177, s[12:13] offset:0
    s_mov_b32 m0, 36672
    s_nop 0
    global_load_lds_dwordx4 v178, s[12:13] offset:0
    s_mov_b32 m0, 37696
    s_nop 0
    global_load_lds_dwordx4 v179, s[12:13] offset:0
    s_mov_b32 m0, 38592
    s_nop 0
    global_load_lds_dwordx4 v172, s[12:13] offset:128
    s_mov_b32 m0, 39616
    s_nop 0
    global_load_lds_dwordx4 v173, s[12:13] offset:128
    s_mov_b32 m0, 40640
    s_nop 0
    global_load_lds_dwordx4 v174, s[12:13] offset:128
    s_mov_b32 m0, 41664
    s_nop 0
    global_load_lds_dwordx4 v175, s[12:13] offset:128
    s_mov_b32 m0, 42688
    s_nop 0
    global_load_lds_dwordx4 v176, s[12:13] offset:128
    s_mov_b32 m0, 43712
    s_nop 0
    global_load_lds_dwordx4 v177, s[12:13] offset:128
    s_mov_b32 m0, 44736
    s_nop 0
    global_load_lds_dwordx4 v178, s[12:13] offset:128
    s_mov_b32 m0, 45760
    s_nop 0
    global_load_lds_dwordx4 v179, s[12:13] offset:128
    s_mov_b32 m0, 46656
    s_nop 0
    global_load_lds_dwordx4 v172, s[12:13] offset:256
    s_mov_b32 m0, 47680
    s_nop 0
    global_load_lds_dwordx4 v173, s[12:13] offset:256
    s_mov_b32 m0, 48704
    s_nop 0
    global_load_lds_dwordx4 v174, s[12:13] offset:256
    s_mov_b32 m0, 49728
    s_nop 0
    global_load_lds_dwordx4 v175, s[12:13] offset:256
    s_mov_b32 m0, 50752
    s_nop 0
    global_load_lds_dwordx4 v176, s[12:13] offset:256
    s_mov_b32 m0, 51776
    s_nop 0
    global_load_lds_dwordx4 v177, s[12:13] offset:256
    s_mov_b32 m0, 52800
    s_nop 0
    global_load_lds_dwordx4 v178, s[12:13] offset:256
    s_mov_b32 m0, 53824
    s_nop 0
    global_load_lds_dwordx4 v179, s[12:13] offset:256
    s_mov_b32 m0, 54720
    s_nop 0
    global_load_lds_dwordx4 v172, s[12:13] offset:384
    s_mov_b32 m0, 55744
    s_nop 0
    global_load_lds_dwordx4 v173, s[12:13] offset:384
    s_mov_b32 m0, 56768
    s_nop 0
    global_load_lds_dwordx4 v174, s[12:13] offset:384
    s_mov_b32 m0, 57792
    s_nop 0
    global_load_lds_dwordx4 v175, s[12:13] offset:384
    s_mov_b32 m0, 58816
    s_nop 0
    global_load_lds_dwordx4 v176, s[12:13] offset:384
    s_mov_b32 m0, 59840
    s_nop 0
    global_load_lds_dwordx4 v177, s[12:13] offset:384
    s_mov_b32 m0, 60864
    s_nop 0
    global_load_lds_dwordx4 v178, s[12:13] offset:384
    s_mov_b32 m0, 61888
    s_nop 0
    global_load_lds_dwordx4 v179, s[12:13] offset:384
    s_barrier
    s_setprio 1
    s_waitcnt vmcnt(32)
    s_call_b64 s[96:97], Lgelu
    s_waitcnt vmcnt(0)
    s_mov_b32 exec_lo, 0x1
    s_mov_b32 exec_hi, 0x0
    s_waitcnt lgkmcnt(0)
    ds_add_u32 v10, v27 offset:23344
    s_mov_b64 exec, -1
    s_waitcnt lgkmcnt(0)
    s_barrier
    s_branch Ldone
LproKV:
    s_cmp_lg_u32 s33, 7
    s_cbranch_scc1 Lnopf
    s_cmp_ge_u32 s32, 4
    s_cbranch_scc1 Lnopf
    s_getpc_b64 s[56:57]
Lpc0:
    v_lshlrev_b32 v2, 7, v1
    v_subrev_u32 v2, Lpc0-recurrent_scan__sliding_block_cached__mixer_token_mlp__decode_kernel, v2
    v_add_u32 v3, 0x2000, v2
    v_min_i32 v3, Lcodeend-Lpc0, v3
    s_sub_u32 s56, s56, 0x2000
    s_subb_u32 s57, s57, 0
    v_add_u32 v2, 0x2000, v2
    v_add_u32 v3, 0x2000, v3
    global_load_dword v26, v2, s[56:57]
    global_load_dword v26, v3, s[56:57]
Lnopf:
    s_sub_u32 s33, s33, 4
    v_mov_b32 v10, 0
    v_mov_b32 v108, 0
    v_mov_b32 v109, 0
    v_mov_b32 v110, 0
    v_mov_b32 v111, 0
    ds_write_b128 v10, v[108:111] offset:23328
    ds_write_b128 v10, v[108:111] offset:23344
    v_mov_b32 v27, 1
    s_waitcnt lgkmcnt(0)
    s_barrier
    s_lshl_b32 s30, s31, 5
    s_add_u32 s30, s30, s32
    s_lshl_b32 s37, s30, 3
    v_mov_b32 v5, s37
    v_mov_b32 v10, 0
    v_mov_b32 v27, 1
    v_mov_b32 v204, 0
    v_mov_b32 v205, 0
    v_mov_b32 v206, 0
    v_mov_b32 v207, 0
    v_mov_b32 v208, 0
    v_mov_b32 v209, 0
    v_mov_b32 v210, 0
    v_mov_b32 v211, 0
    v_mov_b32 v212, 0
    v_mov_b32 v213, 0
    v_mov_b32 v214, 0
    v_mov_b32 v215, 0
    v_mov_b32 v216, 0
    v_mov_b32 v217, 0
    v_mov_b32 v218, 0
    v_mov_b32 v219, 0
    v_mov_b32 v220, 0
    v_mov_b32 v221, 0
    v_mov_b32 v222, 0
    v_mov_b32 v223, 0
    v_mov_b32 v224, 0
    v_mov_b32 v225, 0
    v_mov_b32 v226, 0
    v_mov_b32 v227, 0
    v_mov_b32 v228, 0
    v_mov_b32 v229, 0
    v_mov_b32 v230, 0
    v_mov_b32 v231, 0
    v_mov_b32 v232, 0
    v_mov_b32 v24, 0
    v_and_b32 v114, 15, v1
    v_lshrrev_b32 v115, 4, v1
    v_and_b32 v116, 7, v1
    v_and_b32 v117, 3, v1
    s_lshr_b32 s55, s31, 1
    s_lshl_b32 s55, s55, 24
    s_and_b32 s37, s30, 63
    s_lshl_b32 s37, s37, 14
    s_add_u32 s55, s55, s37
    s_add_u32 s55, s55, 0xf00000
    s_lshl_b32 s37, s33, 12
    s_add_u32 s55, s55, s37
    s_add_u32 m0, s37, 0
    v_lshlrev_b32 v210, 1, v115
    v_xor_b32 v210, v210, v114
    v_lshlrev_b32 v208, 8, v114
    v_lshl_add_u32 v208, v115, 4, v208
    v_add_u32 v208, s55, v208
    v_lshlrev_b32 v210, 4, v210
    v_lshl_add_u32 v209, v115, 8, v210
    v_add_u32 v209, s55, v209
    v_xor_b32 v210, 0x80, v209
    global_load_dwordx2 v[18:19], v5, s[4:5]
    s_mov_b32 s45, 33554432
Lls3:
    ds_read_b32 v2, v10 offset:23328
    s_waitcnt lgkmcnt(0)
    v_cmp_gt_u32 vcc, 1, v2
    s_cbranch_vccz Lls3_ok
    s_sleep 1
    s_sub_u32 s45, s45, 1
    s_cmp_lg_u32 s45, 0
    s_cbranch_scc1 Lls3
    s_branch Lend
Lls3_ok:
    global_load_dwordx4 v[76:79], v208, s[6:7] offset:0
    global_load_dwordx4 v[80:83], v208, s[6:7] offset:64
    global_load_dwordx4 v[84:87], v208, s[6:7] offset:128
    global_load_dwordx4 v[88:91], v208, s[6:7] offset:192
    s_mov_b32 s45, 33554432
Lls4:
    ds_read_b32 v2, v10 offset:23332
    s_waitcnt lgkmcnt(0)
    v_cmp_gt_u32 vcc, 4, v2
    s_cbranch_vccz Lls4_ok
    s_sleep 1
    s_sub_u32 s45, s45, 1
    s_cmp_lg_u32 s45, 0
    s_cbranch_scc1 Lls4
    s_branch Lend
Lls4_ok:
    global_load_lds_dwordx4 v209, s[8:9] offset:0
    global_load_lds_dwordx4 v210, s[8:9] offset:1024
    global_load_lds_dwordx4 v209, s[8:9] offset:2048
    global_load_lds_dwordx4 v210, s[8:9] offset:3072
    s_mov_b32 s50, 0x0c0c0400
    s_mov_b32 s51, 0x04000c0c
    s_mov_b32 s54, 0x3fb8aa3b
    s_mov_b32 s52, 0x3db504f3
    s_mov_b32 s53, s52
    v_lshlrev_b32 v2, 4, v117
    v_mov_b32 v108, 0xffff
    v_mov_b32 v109, 0
    v_lshlrev_b64 v[108:109], v2, v[108:109]
    v_and_b32 v2, 4, v1
    v_cmp_eq_u32 vcc, 0, v2
    s_nop 1
    v_cndmask_b32 v6, 0, v108, vcc
    v_cndmask_b32 v7, 0, v109, vcc
    v_cndmask_b32 v8, v108, v10, vcc
    v_cndmask_b32 v9, v109, v10, vcc
    s_mov_b32 s46, 0x07060500
    s_mov_b32 s47, 0x07060501
    s_mov_b32 s48, 0x07060502
    s_mov_b32 s49, 0x07060503
    v_and_b32 v111, 127, v0
    v_bfe_u32 v110, v0, 7, 1
    v_lshlrev_b32 v111, 4, v111
    v_lshl_add_u32 v111, v110, 13, v111
    s_and_b32 s36, s31, 6
    s_lshl_b32 s36, s36, 13
    s_add_u32 s36, s36, 0x2000
    v_add_u32 v211, s36, v111
    v_bfe_u32 v110, v0, 5, 3
    v_mul_u32_u24 v110, 272, v110
    v_and_b32 v111, 31, v0
    v_lshl_add_u32 v212, v111, 3, v110
    v_mul_u32_u24 v110, 272, v116
    v_lshl_add_u32 v213, v115, 4, v110
    v_lshlrev_b32 v217, 3, v1
    s_lshl_b32 s36, s33, 9
    v_add_u32 v214, s36, v217
    s_lshl_b32 s36, s33, 3
    v_lshl_add_u32 v215, v1, 5, s36
    v_lshlrev_b32 v218, 5, v116
    v_lshrrev_b32 v110, 2, v1
    v_and_b32 v111, 7, v110
    v_lshlrev_b32 v111, 1, v111
    v_bfe_u32 v112, v1, 1, 1
    s_lshl_b32 s36, s33, 2
    v_add_u32 v112, s36, v112
    v_xor_b32 v112, v112, v111
    v_lshlrev_b32 v112, 4, v112
    v_lshl_add_u32 v112, v110, 8, v112
    v_and_b32 v113, 1, v1
    v_lshl_add_u32 v216, v113, 3, v112
    s_lshl_b32 s36, s30, 12
    s_lshl_b32 s37, s33, 10
    s_add_u32 s36, s36, s37
    s_add_u32 s36, s36, 0x20000
    v_bfe_u32 v111, v1, 3, 1
    v_lshlrev_b32 v111, 9, v111
    v_lshl_add_u32 v110, v116, 6, v111
    v_lshl_add_u32 v110, v115, 4, v110
    v_add_u32 v219, s36, v110
    s_lshr_b32 s36, s32, 2
    s_and_b32 s36, s36, 3
    s_lshl_b32 s36, s36, 1
    s_lshr_b32 s37, s33, 1
    s_add_u32 s36, s36, s37
    s_and_b32 s37, s31, 1
    s_lshl_b32 s37, s37, 1
    s_lshr_b32 s38, s32, 4
    s_add_u32 s37, s37, s38
    s_lshl_b32 s37, s37, 1
    s_and_b32 s38, s33, 1
    s_add_u32 s37, s37, s38
    s_lshl_b32 s38, s36, 9
    s_lshl_b32 s39, s37, 6
    s_add_u32 s38, s38, s39
    s_lshr_b32 s39, s31, 1
    s_lshl_b32 s39, s39, 18
    s_add_u32 s38, s38, s39
    s_add_u32 s38, s38, 0x20000
    v_lshrrev_b32 v110, 2, v1
    v_lshlrev_b32 v110, 12, v110
    v_lshl_add_u32 v110, v117, 4, v110
    v_add_u32 v220, s38, v110
    s_mov_b32 s37, 0x10000
    v_add_u32 v221, s37, v220
    v_add_u32 v222, s37, v221
    v_add_u32 v223, s37, v222
    s_lshl_b32 s38, s33, 6
    v_lshl_add_u32 v110, v117, 4, s38
    v_lshl_add_u32 v224, v115, 2, v110
    v_lshrrev_b32 v110, 3, v1
    v_lshlrev_b32 v225, 5, v110
    s_lshr_b32 s36, s32, 4
    s_lshl_b32 s36, s36, 1
    s_lshl_b32 s37, s31, 2
    s_add_u32 s36, s36, s37
    s_lshl_b32 s36, s36, 7
    s_lshr_b32 s37, s32, 2
    s_and_b32 s37, s37, 3
    s_lshl_b32 s37, s37, 5
    s_add_u32 s36, s36, s37
    v_bfe_u32 v111, v1, 4, 1
    v_lshlrev_b32 v111, 7, v111
    v_bfe_u32 v112, v1, 5, 1
    v_lshl_add_u32 v111, v112, 4, v111
    v_and_b32 v112, 8, v1
    v_add3_u32 v111, v111, v112, s36
    v_lshlrev_b32 v111, 11, v111
    s_and_b32 s36, s32, 3
    s_lshl_b32 s36, s36, 9
    s_lshl_b32 s37, s33, 7
    s_add_u32 s36, s36, s37
    v_lshl_add_u32 v112, v116, 4, s36
    v_add_u32 v226, v111, v112
    s_movk_i32 s36, 0x1000
    v_add_u32 v227, s36, v226
    v_add_u32 v228, s36, v227
    v_add_u32 v229, s36, v228
    s_lshl_b32 s36, s31, 3
    s_lshr_b32 s37, s32, 2
    s_add_u32 s36, s36, s37
    s_lshl_b32 s36, s36, 13
    s_and_b32 s37, s32, 3
    s_lshl_b32 s37, s37, 11
    s_add_u32 s36, s36, s37
    s_lshl_b32 s37, s33, 9
    s_add_u32 s36, s36, s37
    s_add_u32 s36, s36, 0x120000
    v_lshlrev_b32 v110, 6, v116
    v_bfe_u32 v111, v1, 4, 1
    v_lshl_add_u32 v110, v111, 5, v110
    v_lshrrev_b32 v111, 5, v1
    v_lshl_add_u32 v110, v111, 4, v110
    v_add_u32 v230, s36, v110
    s_lshl_b32 s36, s30, 5
    s_add_u32 s36, s36, 0x120000
    v_lshlrev_b32 v110, 13, v1
    v_add_u32 v231, s36, v110
    s_lshl_b32 s36, s30, 3
    v_lshl_add_u32 v232, v115, 1, s36
    s_add_u32 s36, s33, 3
    s_lshl_b32 s36, s36, 10
    v_lshl_add_u32 v24, v1, 4, s36
    v_add_u32 v207, 23360, v24
    s_mov_b32 s40, 0xbdd2d3e8
    s_mov_b32 s41, s40
    s_mov_b32 s42, 1.0
    s_mov_b32 s43, 1.0
    ds_read_b32 v11, v10 offset:23312
    ds_read_b32 v35, v10 offset:23316
    ds_read_b128 v[28:31], v10 offset:23296
    s_waitcnt vmcnt(8) lgkmcnt(0)
    s_call_b64 s[96:97], Lh
    global_load_ushort v5, v10, s[22:23]
    s_waitcnt vmcnt(1)
    s_setprio 3
    s_mov_b64 s[14:15], -1
    s_mov_b64 s[56:57], -1
    s_mov_b64 s[58:59], -1
    s_mov_b64 s[98:99], -1
    s_mov_b32 s45, 4194304
Lqpoll:
    s_mov_b64 exec, s[14:15]
    global_load_dwordx4 v[92:95], v211, s[28:29] offset:-4096 sc1
    s_mov_b64 exec, s[56:57]
    global_load_dwordx4 v[96:99], v211, s[28:29] offset:-2048 sc1
    s_mov_b64 exec, s[58:59]
    global_load_dwordx4 v[100:103], v211, s[28:29] sc1
    s_mov_b64 exec, s[98:99]
    global_load_dwordx4 v[104:107], v211, s[28:29] offset:2048 sc1
    s_mov_b64 exec, -1
    s_waitcnt vmcnt(0)
    v_perm_b32 v40, v93, v92, s50
    v_perm_b32 v41, v95, v94, s51
    v_bitop3_b32 v36, v40, v41, v11 bitop3:0x56
    v_cmp_ne_u32 s[14:15], 0, v36
    v_perm_b32 v40, v97, v96, s50
    v_perm_b32 v41, v99, v98, s51
    v_bitop3_b32 v37, v40, v41, v11 bitop3:0x56
    v_cmp_ne_u32 s[56:57], 0, v37
    v_perm_b32 v40, v101, v100, s50
    v_perm_b32 v41, v103, v102, s51
    v_bitop3_b32 v38, v40, v41, v11 bitop3:0x56
    v_cmp_ne_u32 s[58:59], 0, v38
    v_perm_b32 v40, v105, v104, s50
    v_perm_b32 v41, v107, v106, s51
    v_bitop3_b32 v39, v40, v41, v11 bitop3:0x56
    v_cmp_ne_u32 s[98:99], 0, v39
    s_or_b64 vcc, s[14:15], s[56:57]
    s_or_b64 s[2:3], s[58:59], s[98:99]
    s_or_b64 vcc, vcc, s[2:3]
    s_cbranch_scc0 Lqpoll_ok
    s_sleep 1
    s_sub_u32 s45, s45, 1
    s_cmp_lg_u32 s45, 0
    s_cbranch_scc1 Lqpoll
    s_branch Lend
Lqpoll_ok:
    v_pk_add_f32 v[92:93], v[92:93], v[96:97]
    v_pk_add_f32 v[94:95], v[94:95], v[98:99]
    v_pk_add_f32 v[100:101], v[100:101], v[104:105]
    v_pk_add_f32 v[102:103], v[102:103], v[106:107]
    v_pk_add_f32 v[92:93], v[92:93], v[100:101]
    v_pk_add_f32 v[94:95], v[94:95], v[102:103]
    v_cvt_pk_bf16_f32 v92, v92, v93
    v_cvt_pk_bf16_f32 v93, v94, v95
    ds_write_b64 v212, v[92:93] offset:18560
    s_waitcnt lgkmcnt(0)
    s_barrier
    ds_read_b128 v[148:151], v213 offset:18560
    ds_read_b128 v[152:155], v213 offset:18624
    ds_read_b128 v[156:159], v213 offset:18688
    ds_read_b128 v[160:163], v213 offset:18752
    v_xor_b32 v2, 32, v216
    ds_read_b64_tr_b16 v[124:125], v216 offset:0
    ds_read_b64_tr_b16 v[126:127], v2 offset:0
    ds_read_b64_tr_b16 v[128:129], v216 offset:4096
    ds_read_b64_tr_b16 v[130:131], v2 offset:4096
    ds_read_b64_tr_b16 v[132:133], v216 offset:8192
    ds_read_b64_tr_b16 v[134:135], v2 offset:8192
    ds_read_b64_tr_b16 v[136:137], v216 offset:12288
    ds_read_b64_tr_b16 v[138:139], v2 offset:12288
    s_cmp_eq_u32 s33, 0
    s_cbranch_scc1 Lnowb
    global_load_dwordx4 v[236:239], v24, s[16:17]
    global_load_dwordx4 v[240:243], v24, s[18:19]
    global_load_dwordx4 v[244:247], v24, s[20:21]
Lnowb:
    s_waitcnt lgkmcnt(8)
    v_mfma_f32_16x16x32_bf16 v[36:39], v[76:79], v[148:151], 0
    v_mfma_f32_16x16x32_bf16 v[36:39], v[80:83], v[152:155], v[36:39]
    v_mfma_f32_16x16x32_bf16 v[36:39], v[84:87], v[156:159], v[36:39]
    v_mfma_f32_16x16x32_bf16 v[36:39], v[88:91], v[160:163], v[36:39]
    s_nop 7
    v_cvt_pk_bf16_f32 v42, v36, v37
    v_cvt_pk_bf16_f32 v43, v38, v39
    v_lshlrev_b32 v36, 16, v42
    v_and_b32 v37, 0xffff0000, v42
    v_lshlrev_b32 v38, 16, v43
    v_and_b32 v39, 0xffff0000, v43
    v_pk_mul_f32 v[36:37], v[36:37], s[52:53]
    v_pk_mul_f32 v[38:39], v[38:39], s[52:53]
    v_cvt_pk_bf16_f32 v42, v36, v37
    v_cvt_pk_bf16_f32 v43, v38, v39
    v_lshlrev_b32 v36, 16, v42
    v_and_b32 v37, 0xffff0000, v42
    v_lshlrev_b32 v38, 16, v43
    v_and_b32 v39, 0xffff0000, v43
    v_max3_f32 v40, v36, v37, v38
    v_max_f32 v40, v40, v39
    v_mov_b32 v2, v40
    s_nop 1
    v_permlane16_swap_b32 v40, v2
    v_max_f32 v40, v40, v2
    v_mov_b32 v2, v40
    s_nop 1
    v_permlane32_swap_b32 v40, v2
    v_max_f32 v40, v40, v2
    v_mul_f32 v40, s54, v40
    v_fma_f32 v36, v36, s54, -v40
    v_fma_f32 v37, v37, s54, -v40
    v_fma_f32 v38, v38, s54, -v40
    v_fma_f32 v39, v39, s54, -v40
    v_exp_f32 v36, v36
    v_exp_f32 v37, v37
    v_exp_f32 v38, v38
    v_exp_f32 v39, v39
    v_add_f32 v41, v36, v37
    v_cvt_pk_bf16_f32 v42, v36, v37
    v_add_f32 v2, v38, v39
    v_cvt_pk_bf16_f32 v43, v38, v39
    v_add_f32 v41, v41, v2
    ds_write_b64 v214, v[42:43] offset:20736
    v_mov_b32 v2, v41
    s_nop 1
    v_permlane16_swap_b32 v41, v2
    v_add_f32 v41, v41, v2
    v_mov_b32 v2, v41
    s_nop 1
    v_permlane32_swap_b32 v41, v2
    v_add_f32 v41, v41, v2
    s_mov_b32 exec_lo, 0xff
    s_mov_b32 exec_hi, 0x0
    ds_write_b64 v215, v[40:41] offset:22784
    s_mov_b64 exec, -1
    s_waitcnt lgkmcnt(0)
    s_barrier
    ds_read_b64 v[148:149], v217 offset:20736
    ds_read_b64 v[150:151], v217 offset:21248
    ds_read_b64 v[152:153], v217 offset:21760
    ds_read_b64 v[154:155], v217 offset:22272
    ds_read_b128 v[108:111], v218 offset:22784
    ds_read_b128 v[112:115], v218 offset:22800
    s_waitcnt lgkmcnt(5)
    v_mfma_f32_16x16x16_bf16 v[44:47], v[124:125], v[148:149], 0
    v_mfma_f32_16x16x16_bf16 v[48:51], v[126:127], v[148:149], 0
    s_waitcnt lgkmcnt(4)
    v_mfma_f32_16x16x16_bf16 v[52:55], v[128:129], v[150:151], 0
    v_mfma_f32_16x16x16_bf16 v[56:59], v[130:131], v[150:151], 0
    s_waitcnt lgkmcnt(3)
    v_mfma_f32_16x16x16_bf16 v[60:63], v[132:133], v[152:153], 0
    v_mfma_f32_16x16x16_bf16 v[64:67], v[134:135], v[152:153], 0
    s_waitcnt lgkmcnt(2)
    v_mfma_f32_16x16x16_bf16 v[68:71], v[136:137], v[154:155], 0
    v_mfma_f32_16x16x16_bf16 v[72:75], v[138:139], v[154:155], 0
    s_waitcnt lgkmcnt(0)
    v_max3_f32 v36, v108, v110, v112
    v_max_f32 v36, v36, v114
    v_sub_f32 v156, v108, v36
    v_sub_f32 v158, v110, v36
    v_sub_f32 v160, v112, v36
    v_sub_f32 v162, v114, v36
    v_exp_f32 v156, v156
    v_exp_f32 v158, v158
    v_exp_f32 v160, v160
    v_exp_f32 v162, v162
    v_mul_f32 v37, v156, v109
    v_fmac_f32 v37, v158, v111
    v_fmac_f32 v37, v160, v113
    v_fmac_f32 v37, v162, v115
    s_mov_b32 vcc_lo, 0xFF00FF00
    s_mov_b32 vcc_hi, 0xFF00FF00
    v_rcp_f32 v4, v37
    v_log_f32 v3, v37
    v_pk_mul_f32 v[164:165], v[44:45], v[156:157] op_sel_hi:[1,0]
    v_pk_mul_f32 v[166:167], v[46:47], v[156:157] op_sel_hi:[1,0]
    v_pk_mul_f32 v[168:169], v[48:49], v[156:157] op_sel_hi:[1,0]
    v_pk_mul_f32 v[170:171], v[50:51], v[156:157] op_sel_hi:[1,0]
    v_pk_fma_f32 v[164:165], v[52:53], v[158:159], v[164:165] op_sel_hi:[1,0,1]
    v_pk_fma_f32 v[166:167], v[54:55], v[158:159], v[166:167] op_sel_hi:[1,0,1]
    v_pk_fma_f32 v[168:169], v[56:57], v[158:159], v[168:169] op_sel_hi:[1,0,1]
    v_pk_fma_f32 v[170:171], v[58:59], v[158:159], v[170:171] op_sel_hi:[1,0,1]
    v_pk_fma_f32 v[164:165], v[60:61], v[160:161], v[164:165] op_sel_hi:[1,0,1]
    v_pk_fma_f32 v[166:167], v[62:63], v[160:161], v[166:167] op_sel_hi:[1,0,1]
    v_pk_fma_f32 v[168:169], v[64:65], v[160:161], v[168:169] op_sel_hi:[1,0,1]
    v_pk_fma_f32 v[170:171], v[66:67], v[160:161], v[170:171] op_sel_hi:[1,0,1]
    v_pk_fma_f32 v[164:165], v[68:69], v[162:163], v[164:165] op_sel_hi:[1,0,1]
    v_pk_fma_f32 v[166:167], v[70:71], v[162:163], v[166:167] op_sel_hi:[1,0,1]
    v_pk_fma_f32 v[168:169], v[72:73], v[162:163], v[168:169] op_sel_hi:[1,0,1]
    v_pk_fma_f32 v[170:171], v[74:75], v[162:163], v[170:171] op_sel_hi:[1,0,1]
    v_cndmask_b32 v164, v164, v168, vcc
    v_cndmask_b32 v165, v165, v169, vcc
    v_cndmask_b32 v166, v166, v170, vcc
    v_cndmask_b32 v167, v167, v171, vcc
    v_pk_mul_f32 v[164:165], v[164:165], v[4:5] op_sel_hi:[1,0]
    v_pk_mul_f32 v[166:167], v[166:167], v[4:5] op_sel_hi:[1,0]
    v_add_f32 v118, v36, v3
    v_mov_b32 v119, v11
    v_cvt_pk_bf16_f32 v116, v164, v165
    v_cvt_pk_bf16_f32 v117, v166, v167
    s_waitcnt vmcnt(0)
    global_store_dwordx4 v219, v[116:119], s[28:29] sc1
    s_cmp_eq_u32 s33, 0
    s_cbranch_scc1 Lw4sleep
    s_setprio 2
    v_mov_b32 v124, v236
    v_mov_b32 v125, v237
    v_mov_b32 v126, v238
    v_mov_b32 v127, v239
    v_mov_b32 v128, v240
    v_mov_b32 v129, v241
    v_mov_b32 v130, v242
    v_mov_b32 v131, v243
    v_mov_b32 v132, v244
    v_mov_b32 v133, v245
    v_mov_b32 v134, v246
    v_mov_b32 v135, v247
    s_call_b64 s[96:97], Lgelu
    s_setprio 3
    s_branch Lw4done
Lw4sleep:
Lw4done:
    s_mov_b32 s45, 33554432
Lls5:
    ds_read_b32 v2, v10 offset:23344
    s_waitcnt lgkmcnt(0)
    v_cmp_gt_u32 vcc, 1, v2
    s_cbranch_vccz Lls5_ok
    s_sleep 1
    s_sub_u32 s45, s45, 1
    s_cmp_lg_u32 s45, 0
    s_cbranch_scc1 Lls5
    s_branch Lend
Lls5_ok:
    s_lshl_b32 s36, s33, 13
    v_lshl_add_u32 v2, v1, 4, s36
    ds_read_b128 v[172:175], v2 offset:30528
    ds_read_b128 v[176:179], v2 offset:31552
    ds_read_b128 v[180:183], v2 offset:32576
    ds_read_b128 v[184:187], v2 offset:33600
    ds_read_b128 v[188:191], v2 offset:34624
    ds_read_b128 v[192:195], v2 offset:35648
    ds_read_b128 v[196:199], v2 offset:36672
    ds_read_b128 v[200:203], v2 offset:37696
    s_mov_b64 s[14:15], -1
    s_mov_b64 s[56:57], -1
    s_mov_b64 s[58:59], -1
    s_mov_b64 s[98:99], -1
    s_mov_b32 s45, 4194304
Lopoll:
    s_mov_b64 exec, s[14:15]
    global_load_dwordx4 v[76:79], v220, s[28:29] sc1
    s_mov_b64 exec, s[56:57]
    global_load_dwordx4 v[80:83], v221, s[28:29] sc1
    s_mov_b64 exec, s[58:59]
    global_load_dwordx4 v[84:87], v222, s[28:29] sc1
    s_mov_b64 exec, s[98:99]
    global_load_dwordx4 v[88:91], v223, s[28:29] sc1
    s_mov_b64 exec, -1
    s_waitcnt vmcnt(0)
    v_cmp_ne_u32 s[14:15], v79, v11
    v_cmp_ne_u32 s[56:57], v83, v11
    v_cmp_ne_u32 s[58:59], v87, v11
    v_cmp_ne_u32 s[98:99], v91, v11
    s_or_b64 vcc, s[14:15], s[56:57]
    s_or_b64 s[2:3], s[58:59], s[98:99]
    s_or_b64 vcc, vcc, s[2:3]
    s_cbranch_scc0 Lopoll_ok
    s_sleep 1
    s_sub_u32 s45, s45, 1
    s_cmp_lg_u32 s45, 0
    s_cbranch_scc1 Lopoll
    s_branch Lend
Lopoll_ok:
    v_max3_f32 v40, v78, v82, v86
    v_max_f32 v40, v40, v90
    v_lshlrev_b32 v52, 16, v76
    v_and_b32 v53, 0xffff0000, v76
    v_max_f32_dpp v40, v40, v40 row_ror:4 row_mask:0xf bank_mask:0xf
    v_lshlrev_b32 v54, 16, v77
    v_and_b32 v55, 0xffff0000, v77
    v_max_f32_dpp v40, v40, v40 row_ror:8 row_mask:0xf bank_mask:0xf
    v_lshlrev_b32 v56, 16, v80
    v_and_b32 v57, 0xffff0000, v80
    v_mov_b32 v2, v40
    v_lshlrev_b32 v58, 16, v81
    v_and_b32 v59, 0xffff0000, v81
    v_permlane16_swap_b32 v40, v2
    v_max_f32 v40, v40, v2
    v_lshlrev_b32 v60, 16, v84
    v_and_b32 v61, 0xffff0000, v84
    v_mov_b32 v2, v40
    v_lshlrev_b32 v62, 16, v85
    v_and_b32 v63, 0xffff0000, v85
    v_permlane32_swap_b32 v40, v2
    v_max_f32 v40, v40, v2
    v_lshlrev_b32 v64, 16, v88
    v_and_b32 v65, 0xffff0000, v88
    v_sub_f32 v44, v78, v40
    v_sub_f32 v46, v82, v40
    v_sub_f32 v48, v86, v40
    v_sub_f32 v50, v90, v40
    v_lshlrev_b32 v66, 16, v89
    v_and_b32 v67, 0xffff0000, v89
    v_exp_f32 v44, v44
    v_exp_f32 v46, v46
    v_exp_f32 v48, v48
    v_exp_f32 v50, v50
    v_pk_mul_f32 v[36:37], v[52:53], v[44:45] op_sel_hi:[1,0]
    v_pk_mul_f32 v[38:39], v[54:55], v[44:45] op_sel_hi:[1,0]
    v_add_f32 v40, v44, v46
    v_pk_fma_f32 v[36:37], v[56:57], v[46:47], v[36:37] op_sel_hi:[1,0,1]
    v_pk_fma_f32 v[38:39], v[58:59], v[46:47], v[38:39] op_sel_hi:[1,0,1]
    v_add_f32 v41, v48, v50
    v_pk_fma_f32 v[36:37], v[60:61], v[48:49], v[36:37] op_sel_hi:[1,0,1]
    v_pk_fma_f32 v[38:39], v[62:63], v[48:49], v[38:39] op_sel_hi:[1,0,1]
    v_add_f32 v40, v40, v41
    v_pk_fma_f32 v[36:37], v[64:65], v[50:51], v[36:37] op_sel_hi:[1,0,1]
    v_pk_fma_f32 v[38:39], v[66:67], v[50:51], v[38:39] op_sel_hi:[1,0,1]
    v_mov_b32 v2, v40
    s_nop 0
    v_permlane32_swap_b32 v36, v38
    v_permlane32_swap_b32 v37, v39
    v_permlane32_swap_b32 v40, v2
    v_add_f32 v36, v36, v38
    v_add_f32 v37, v37, v39
    v_add_f32 v40, v40, v2
    v_mov_b32 v2, v40
    v_permlane16_swap_b32 v36, v37
    s_nop 0
    v_permlane16_swap_b32 v40, v2
    v_add_f32 v36, v36, v37
    v_add_f32 v40, v40, v2
    s_nop 0
    v_add_f32_dpp v36, v36, v36 row_ror:4 row_mask:0xf bank_mask:0xf
    v_add_f32_dpp v40, v40, v40 row_ror:4 row_mask:0xf bank_mask:0xf
    s_nop 0
    v_add_f32_dpp v36, v36, v36 row_ror:8 row_mask:0xf bank_mask:0xf
    v_add_f32_dpp v40, v40, v40 row_ror:8 row_mask:0xf bank_mask:0xf
    v_rcp_f32 v40, v40
    s_nop 0
    v_mul_f32 v36, v36, v40
    v_cvt_pk_bf16_f32 v36, v36, v36
    s_mov_b32 exec_lo, 0xf000f
    s_mov_b32 exec_hi, 0xf000f
    ds_write_b32 v224, v36 offset:23040
    s_mov_b64 exec, -1
    s_waitcnt lgkmcnt(0)
    s_barrier
    ds_read_b128 v[36:39], v225 offset:23040
    ds_read_b128 v[40:43], v225 offset:23056
    s_waitcnt lgkmcnt(1)
    v_and_b32 v44, v36, v6
    v_and_b32 v45, v36, v7
    v_and_b32 v46, v36, v8
    v_and_b32 v47, v36, v9
    v_and_b32 v48, v37, v6
    v_and_b32 v49, v37, v7
    v_and_b32 v50, v37, v8
    v_and_b32 v51, v37, v9
    v_mfma_f32_16x16x32_bf16 v[108:111], v[44:47], v[172:175], 0
    v_and_b32 v52, v38, v6
    v_and_b32 v53, v38, v7
    v_and_b32 v54, v38, v8
    v_and_b32 v55, v38, v9
    v_mfma_f32_16x16x32_bf16 v[108:111], v[48:51], v[176:179], v[108:111]
    v_and_b32 v56, v39, v6
    v_and_b32 v57, v39, v7
    v_and_b32 v58, v39, v8
    v_and_b32 v59, v39, v9
    v_mfma_f32_16x16x32_bf16 v[108:111], v[52:55], v[180:183], v[108:111]
    s_waitcnt lgkmcnt(0)
    v_and_b32 v60, v40, v6
    v_and_b32 v61, v40, v7
    v_and_b32 v62, v40, v8
    v_and_b32 v63, v40, v9
    v_mfma_f32_16x16x32_bf16 v[108:111], v[56:59], v[184:187], v[108:111]
    v_and_b32 v64, v41, v6
    v_and_b32 v65, v41, v7
    v_and_b32 v66, v41, v8
    v_and_b32 v67, v41, v9
    v_mfma_f32_16x16x32_bf16 v[108:111], v[60:63], v[188:191], v[108:111]
    v_and_b32 v68, v42, v6
    v_and_b32 v69, v42, v7
    v_and_b32 v70, v42, v8
    v_and_b32 v71, v42, v9
    v_mfma_f32_16x16x32_bf16 v[108:111], v[64:67], v[192:195], v[108:111]
    v_and_b32 v72, v43, v6
    v_and_b32 v73, v43, v7
    v_and_b32 v74, v43, v8
    v_and_b32 v75, v43, v9
    v_mfma_f32_16x16x32_bf16 v[108:111], v[68:71], v[196:199], v[108:111]
    s_nop 0
    v_mfma_f32_16x16x32_bf16 v[108:111], v[72:75], v[200:203], v[108:111]
    s_nop 7
    v_perm_b32 v108, v108, v11, s46
    v_perm_b32 v109, v109, v11, s47
    v_perm_b32 v110, v110, v11, s48
    v_perm_b32 v111, v111, v11, s49
    s_mov_b32 exec_lo, 0xff00ff
    s_mov_b32 exec_hi, 0xff00ff00
    global_store_dwordx4 v230, v[108:111], s[28:29] sc1
    s_mov_b64 exec, -1
    s_cmp_lg_u32 s33, 0
    s_cbranch_scc1 Ldone
    v_lshlrev_b32 v2, 4, v1
    ds_read_b128 v[148:151], v2 offset:23360
    ds_read_b128 v[152:155], v2 offset:24384
    ds_read_b128 v[156:159], v2 offset:25408
    ds_read_b128 v[160:163], v2 offset:26432
    ds_read_b128 v[164:167], v2 offset:27456
    ds_read_b128 v[168:171], v2 offset:28480
    ds_read_b128 v[172:175], v2 offset:29504
    v_cmp_gt_u32 vcc, 32, v1
    s_nop 1
    v_cndmask_b32 v25, v19, v18, vcc
    v_and_b32 v2, 16, v1
    v_cmp_eq_u32 vcc, 0, v2
    v_lshlrev_b32 v3, 16, v25
    v_and_b32 v25, 0xffff0000, v25
    v_cndmask_b32 v25, v25, v3, vcc
    s_waitcnt lgkmcnt(0)
    v_pk_add_f32 v[148:149], v[148:149], v[152:153]
    v_pk_add_f32 v[150:151], v[150:151], v[154:155]
    v_pk_add_f32 v[148:149], v[148:149], v[156:157]
    v_pk_add_f32 v[150:151], v[150:151], v[158:159]
    v_pk_add_f32 v[148:149], v[148:149], v[160:161]
    v_pk_add_f32 v[150:151], v[150:151], v[162:163]
    v_pk_add_f32 v[148:149], v[148:149], v[164:165]
    v_pk_add_f32 v[150:151], v[150:151], v[166:167]
    v_pk_add_f32 v[148:149], v[148:149], v[168:169]
    v_pk_add_f32 v[150:151], v[150:151], v[170:171]
    v_pk_add_f32 v[148:149], v[148:149], v[172:173]
    v_pk_add_f32 v[150:151], v[150:151], v[174:175]
    s_nop 1
    v_permlane32_swap_b32 v148, v150
    v_permlane32_swap_b32 v149, v151
    v_add_f32 v148, v148, v150
    v_add_f32 v149, v149, v151
    s_nop 1
    v_permlane16_swap_b32 v148, v149
    v_add_f32 v148, v148, v149
    s_nop 1
    v_add_f32_dpp v148, v148, v148 row_ror:8 row_mask:0xf bank_mask:0xf
    s_nop 1
    v_add_f32_dpp v148, v148, v148 row_ror:4 row_mask:0xf bank_mask:0xf
    s_nop 1
    v_add_f32_dpp v148, v148, v148 row_ror:2 row_mask:0xf bank_mask:0xf
    s_nop 1
    v_add_f32_dpp v148, v148, v148 row_ror:1 row_mask:0xf bank_mask:0xf
    v_cvt_pk_bf16_f32 v148, v148, v148
    v_lshlrev_b32 v148, 16, v148
    s_waitcnt vmcnt(0)
    v_lshlrev_b32 v5, 16, v5
    v_add_f32 v148, v148, v5
    v_cvt_pk_bf16_f32 v148, v148, v148
    v_lshlrev_b32 v148, 16, v148
    v_mul_f32 v149, 0xbfb8aa3b, v148
    v_exp_f32 v149, v149
    s_nop 0
    v_add_f32 v149, 1.0, v149
    v_rcp_f32 v149, v149
    s_nop 0
    v_mul_f32 v148, v148, v149
    v_cvt_pk_bf16_f32 v24, v148, v148
    v_lshlrev_b32 v24, 16, v24
    s_mov_b64 s[14:15], -1
    s_mov_b64 s[56:57], -1
    s_mov_b32 s45, 4194304
Lppoll:
    s_mov_b64 exec, s[14:15]
    global_load_dwordx4 v[44:47], v231, s[28:29] sc1
    s_mov_b64 exec, s[56:57]
    global_load_dwordx4 v[48:51], v231, s[28:29] offset:16 sc1
    s_mov_b64 exec, -1
    s_waitcnt vmcnt(0)
    v_perm_b32 v80, v45, v44, s50
    v_perm_b32 v81, v47, v46, s51
    v_bitop3_b32 v76, v80, v81, v11 bitop3:0x56
    v_cmp_ne_u32 s[14:15], 0, v76
    v_perm_b32 v80, v49, v48, s50
    v_perm_b32 v81, v51, v50, s51
    v_bitop3_b32 v77, v80, v81, v11 bitop3:0x56
    v_cmp_ne_u32 s[56:57], 0, v77
    s_nop 0
    s_or_b64 vcc, s[14:15], s[56:57]
    s_cbranch_scc0 Lppoll_ok
    s_sleep 1
    s_sub_u32 s45, s45, 1
    s_cmp_lg_u32 s45, 0
    s_cbranch_scc1 Lppoll
    s_branch Lend
Lppoll_ok:
    s_cmp_lg_u32 s30, 0
    s_cbranch_scc1 Lnoep
    v_add_u32 v3, 1, v35
    s_mov_b32 exec_lo, 0x1
    s_mov_b32 exec_hi, 0x0
    global_store_dword v10, v3, s[28:29] offset:0
    s_mov_b64 exec, -1
Lnoep:
    v_pk_add_f32 v[44:45], v[44:45], v[48:49]
    v_pk_add_f32 v[46:47], v[46:47], v[50:51]
    s_nop 1
    v_permlane32_swap_b32 v44, v46
    v_permlane32_swap_b32 v45, v47
    v_add_f32 v44, v44, v46
    v_add_f32 v45, v45, v47
    s_nop 1
    v_permlane16_swap_b32 v44, v45
    v_add_f32 v44, v44, v45
    s_nop 1
    v_add_f32_dpp v44, v44, v44 row_ror:8 row_mask:0xf bank_mask:0xf
    s_nop 1
    v_add_f32_dpp v44, v44, v44 row_ror:4 row_mask:0xf bank_mask:0xf
    s_nop 1
    v_add_f32_dpp v44, v44, v44 row_ror:2 row_mask:0xf bank_mask:0xf
    s_nop 1
    v_add_f32_dpp v44, v44, v44 row_ror:1 row_mask:0xf bank_mask:0xf
    v_cvt_pk_bf16_f32 v44, v44, v44
    v_lshlrev_b32 v44, 16, v44
    v_mul_f32 v44, v44, v24
    v_cvt_pk_bf16_f32 v44, v44, v44
    v_lshlrev_b32 v44, 16, v44
    v_add_f32 v44, v44, v25
    v_cvt_pk_bf16_f32 v44, v44, v44
    s_mov_b32 exec_lo, 0x10001
    s_mov_b32 exec_hi, 0x10001
    global_store_short v232, v44, s[24:25]
Ldone:
Lend:
    s_endpgm
Lstat2:
    v_lshlrev_b32 v148, 16, v124
    v_and_b32 v149, 0xffff0000, v124
    v_lshlrev_b32 v150, 16, v125
    v_and_b32 v151, 0xffff0000, v125
    v_lshlrev_b32 v152, 16, v126
    v_and_b32 v153, 0xffff0000, v126
    v_lshlrev_b32 v154, 16, v127
    v_and_b32 v155, 0xffff0000, v127
    v_lshlrev_b32 v156, 16, v128
    v_and_b32 v157, 0xffff0000, v128
    v_lshlrev_b32 v158, 16, v129
    v_and_b32 v159, 0xffff0000, v129
    v_lshlrev_b32 v160, 16, v130
    v_and_b32 v161, 0xffff0000, v130
    v_lshlrev_b32 v162, 16, v131
    v_and_b32 v163, 0xffff0000, v131
    v_pk_add_f32 v[148:149], v[148:149], v[138:139] op_sel_hi:[1,0] neg_lo:[0,1] neg_hi:[0,1]
    v_pk_add_f32 v[150:151], v[150:151], v[138:139] op_sel_hi:[1,0] neg_lo:[0,1] neg_hi:[0,1]
    v_pk_add_f32 v[152:153], v[152:153], v[138:139] op_sel_hi:[1,0] neg_lo:[0,1] neg_hi:[0,1]
    v_pk_add_f32 v[154:155], v[154:155], v[138:139] op_sel_hi:[1,0] neg_lo:[0,1] neg_hi:[0,1]
    v_pk_add_f32 v[156:157], v[156:157], v[138:139] op_sel_hi:[1,0] neg_lo:[0,1] neg_hi:[0,1]
    v_pk_add_f32 v[158:159], v[158:159], v[138:139] op_sel_hi:[1,0] neg_lo:[0,1] neg_hi:[0,1]
    v_pk_add_f32 v[160:161], v[160:161], v[138:139] op_sel_hi:[1,0] neg_lo:[0,1] neg_hi:[0,1]
    v_pk_add_f32 v[162:163], v[162:163], v[138:139] op_sel_hi:[1,0] neg_lo:[0,1] neg_hi:[0,1]
    v_pk_mul_f32 v[134:135], v[148:149], v[148:149]
    v_pk_fma_f32 v[134:135], v[150:151], v[150:151], v[134:135]
    v_pk_fma_f32 v[134:135], v[152:153], v[152:153], v[134:135]
    v_pk_fma_f32 v[134:135], v[154:155], v[154:155], v[134:135]
    v_pk_fma_f32 v[134:135], v[156:157], v[156:157], v[134:135]
    v_pk_fma_f32 v[134:135], v[158:159], v[158:159], v[134:135]
    v_pk_fma_f32 v[134:135], v[160:161], v[160:161], v[134:135]
    v_pk_fma_f32 v[134:135], v[162:163], v[162:163], v[134:135]
    v_add_f32 v134, v134, v135
    s_nop 1
    v_add_f32_dpp v134, v134, v134 row_ror:8 row_mask:0xf bank_mask:0xf
    s_nop 1
    v_add_f32_dpp v134, v134, v134 row_ror:4 row_mask:0xf bank_mask:0xf
    s_nop 1
    v_add_f32_dpp v134, v134, v134 row_ror:2 row_mask:0xf bank_mask:0xf
    s_nop 1
    v_add_f32_dpp v134, v134, v134 row_ror:1 row_mask:0xf bank_mask:0xf
    s_nop 1
    v_add_f32_dpp v134, v134, v134 row_bcast:15 row_mask:0xa bank_mask:0xf
    s_nop 1
    v_add_f32_dpp v134, v134, v134 row_bcast:31 row_mask:0xc bank_mask:0xf
    s_nop 0
    v_readlane_b32 s36, v134, 63
    s_nop 1
    v_mov_b32 v139, s36
    v_mul_f32 v139, 0x3a800000, v139
    s_nop 1
    s_branch Lstat3
Lh:
    v_sub_f32 v30, v30, v28
    v_mul_f32 v36, v31, v29
    v_mul_f32 v30, v30, v29
    v_mul_f32 v36, v36, v29
    v_cvt_pk_bf16_f32 v30, v30, v30
    v_lshlrev_b32 v30, 16, v30
    v_cvt_pk_bf16_f32 v36, v36, v36
    v_lshlrev_b32 v36, 16, v36
    v_add_f32 v36, 0x3727c5ac, v36
    v_cvt_pk_bf16_f32 v36, v36, v36
    v_lshlrev_b32 v36, 16, v36
    v_sqrt_f32 v36, v36
    s_nop 0
    v_cvt_pk_bf16_f32 v36, v36, v36
    v_lshlrev_b32 v36, 16, v36
    v_rcp_f32 v31, v36
    v_lshlrev_b32 v110, 16, v18
    v_and_b32 v111, 0xffff0000, v18
    v_pk_add_f32 v[110:111], v[110:111], v[28:29] op_sel_hi:[1,0] neg_lo:[0,1] neg_hi:[0,1]
    v_cvt_pk_bf16_f32 v20, v110, v111
    v_lshlrev_b32 v110, 16, v20
    v_and_b32 v111, 0xffff0000, v20
    v_pk_mul_f32 v[110:111], v[110:111], v[28:29] op_sel:[0,1] op_sel_hi:[1,1]
    v_cvt_pk_bf16_f32 v20, v110, v111
    v_lshlrev_b32 v112, 16, v19
    v_and_b32 v113, 0xffff0000, v19
    v_pk_add_f32 v[112:113], v[112:113], v[28:29] op_sel_hi:[1,0] neg_lo:[0,1] neg_hi:[0,1]
    v_cvt_pk_bf16_f32 v21, v112, v113
    v_lshlrev_b32 v112, 16, v21
    v_and_b32 v113, 0xffff0000, v21
    v_pk_mul_f32 v[112:113], v[112:113], v[28:29] op_sel:[0,1] op_sel_hi:[1,1]
    v_cvt_pk_bf16_f32 v21, v112, v113
    v_lshlrev_b32 v110, 16, v20
    v_and_b32 v111, 0xffff0000, v20
    v_pk_add_f32 v[110:111], v[110:111], v[30:31] op_sel_hi:[1,0] neg_lo:[0,1] neg_hi:[0,1]
    v_cvt_pk_bf16_f32 v20, v110, v111
    v_lshlrev_b32 v110, 16, v20
    v_and_b32 v111, 0xffff0000, v20
    v_pk_mul_f32 v[110:111], v[110:111], v[30:31] op_sel:[0,1] op_sel_hi:[1,1]
    v_cvt_pk_bf16_f32 v20, v110, v111
    v_lshlrev_b32 v112, 16, v21
    v_and_b32 v113, 0xffff0000, v21
    v_pk_add_f32 v[112:113], v[112:113], v[30:31] op_sel_hi:[1,0] neg_lo:[0,1] neg_hi:[0,1]
    v_cvt_pk_bf16_f32 v21, v112, v113
    v_lshlrev_b32 v112, 16, v21
    v_and_b32 v113, 0xffff0000, v21
    v_pk_mul_f32 v[112:113], v[112:113], v[30:31] op_sel:[0,1] op_sel_hi:[1,1]
    v_cvt_pk_bf16_f32 v21, v112, v113
    v_lshlrev_b32 v22, 16, v21
    v_and_b32 v23, 0xffff0000, v21
    v_and_b32 v21, 0xffff0000, v20
    v_lshlrev_b32 v20, 16, v20
    s_setpc_b64 s[96:97]
Lgelu:
    v_lshlrev_b32 v148, 16, v124
    v_and_b32 v149, 0xffff0000, v124
    v_lshlrev_b32 v156, 16, v128
    v_and_b32 v157, 0xffff0000, v128
    v_lshlrev_b32 v164, 16, v132
    v_and_b32 v165, 0xffff0000, v132
    v_lshlrev_b32 v150, 16, v125
    v_and_b32 v151, 0xffff0000, v125
    v_lshlrev_b32 v158, 16, v129
    v_and_b32 v159, 0xffff0000, v129
    v_lshlrev_b32 v166, 16, v133
    v_and_b32 v167, 0xffff0000, v133
    v_lshlrev_b32 v152, 16, v126
    v_and_b32 v153, 0xffff0000, v126
    v_lshlrev_b32 v160, 16, v130
    v_and_b32 v161, 0xffff0000, v130
    v_lshlrev_b32 v168, 16, v134
    v_and_b32 v169, 0xffff0000, v134
    v_lshlrev_b32 v154, 16, v127
    v_and_b32 v155, 0xffff0000, v127
    v_lshlrev_b32 v162, 16, v131
    v_and_b32 v163, 0xffff0000, v131
    v_lshlrev_b32 v170, 16, v135
    v_and_b32 v171, 0xffff0000, v135
    v_mov_b32 v2, 0xc0135761
    v_mov_b32 v3, 0xc0135761
    s_mov_b32 s36, 4
Lgel:
    v_pk_fma_f32 v[108:109], v[148:149], v[20:21], v[156:157] op_sel_hi:[1,0,1]
    v_pk_fma_f32 v[110:111], v[150:151], v[20:21], v[158:159] op_sel_hi:[1,0,1]
    v_pk_fma_f32 v[112:113], v[152:153], v[20:21], v[160:161] op_sel_hi:[1,0,1]
    v_pk_fma_f32 v[114:115], v[154:155], v[20:21], v[162:163] op_sel_hi:[1,0,1]
    v_pk_mul_f32 v[36:37], v[108:109], v[108:109]
    v_pk_mul_f32 v[38:39], v[110:111], v[110:111]
    v_pk_mul_f32 v[40:41], v[112:113], v[112:113]
    v_pk_mul_f32 v[42:43], v[114:115], v[114:115]
    v_pk_fma_f32 v[36:37], v[36:37], s[40:41], v[2:3]
    v_pk_fma_f32 v[38:39], v[38:39], s[40:41], v[2:3]
    v_pk_fma_f32 v[40:41], v[40:41], s[40:41], v[2:3]
    v_pk_fma_f32 v[42:43], v[42:43], s[40:41], v[2:3]
    v_pk_mul_f32 v[36:37], v[36:37], v[108:109]
    v_pk_mul_f32 v[38:39], v[38:39], v[110:111]
    v_pk_mul_f32 v[40:41], v[40:41], v[112:113]
    v_pk_mul_f32 v[42:43], v[42:43], v[114:115]
    v_exp_f32 v36, v36
    v_exp_f32 v37, v37
    v_exp_f32 v38, v38
    v_exp_f32 v39, v39
    v_exp_f32 v40, v40
    v_exp_f32 v41, v41
    v_exp_f32 v42, v42
    v_exp_f32 v43, v43
    v_pk_mul_f32 v[108:109], v[108:109], v[164:165]
    v_pk_mul_f32 v[110:111], v[110:111], v[166:167]
    v_pk_mul_f32 v[112:113], v[112:113], v[168:169]
    v_pk_mul_f32 v[114:115], v[114:115], v[170:171]
    v_pk_add_f32 v[36:37], v[36:37], s[42:43]
    v_pk_add_f32 v[38:39], v[38:39], s[42:43]
    v_pk_add_f32 v[40:41], v[40:41], s[42:43]
    v_pk_add_f32 v[42:43], v[42:43], s[42:43]
    v_rcp_f32 v36, v36
    v_rcp_f32 v37, v37
    v_rcp_f32 v38, v38
    v_rcp_f32 v39, v39
    v_rcp_f32 v40, v40
    v_rcp_f32 v41, v41
    v_rcp_f32 v42, v42
    v_rcp_f32 v43, v43
    v_mov_b32 v26, v20
    v_pk_mul_f32 v[4:5], v[108:109], v[36:37]
    v_mov_b32 v20, v21
    v_pk_fma_f32 v[4:5], v[110:111], v[38:39], v[4:5]
    v_pk_fma_f32 v[4:5], v[112:113], v[40:41], v[4:5]
    v_pk_fma_f32 v[4:5], v[114:115], v[42:43], v[4:5]
    v_mov_b32 v21, v22
    v_mov_b32 v22, v23
    v_add_f32 v4, v4, v5
    v_mov_b32 v23, v26
    ds_write_b32 v207, v4
    v_add_u32 v207, 4, v207
    s_sub_u32 s36, s36, 1
    s_cmp_lg_u32 s36, 0
    s_cbranch_scc1 Lgel
    s_setpc_b64 s[96:97]
Lcodeend:
    s_endpgm
.section .rodata,"a"
.p2align 6
.amdhsa_kernel recurrent_scan__sliding_block_cached__mixer_token_mlp__decode_kernel
  .amdhsa_next_free_vgpr 248
  .amdhsa_next_free_sgpr 102
  .amdhsa_accum_offset 248
  .amdhsa_group_segment_fixed_size 0
  .amdhsa_kernarg_size 104
  .amdhsa_user_sgpr_count 2
  .amdhsa_user_sgpr_kernarg_segment_ptr 1
  .amdhsa_system_sgpr_workgroup_id_x 1
.end_amdhsa_kernel
```
